```python
import torch

def _softmax(x, axis=-1):
    return torch.softmax(x, dim=axis)
def _gelu(x):
    return torch.nn.functional.gelu(x, approximate="tanh")
def _silu(x):
    return torch.nn.functional.silu(x)
def _sigmoid(x):
    return torch.sigmoid(x)
def _layernorm(x, axis=-1, eps=1e-5):
    m = x.mean(dim=axis, keepdim=True)
    v = x.var(dim=axis, keepdim=True, unbiased=False)
    return (x - m) / torch.sqrt(v + eps)
def _scatter_add(tgt, idx, src, axis=0):
    return tgt.clone().index_add_(axis, idx, src)
def _segment_sum(src, seg, n):
    out = torch.zeros((n,) + src.shape[1:], dtype=src.dtype)
    return out.index_add_(0, seg, src)
def _pad(x, pw):
    flat = tuple(v for pair in reversed(pw) for v in pair)
    return torch.nn.functional.pad(x, flat)

kernel_name = 'gated_mix__sliding_block_cached__swiglu_ffn__decode'

def setup_inputs():

    _w = (lambda a: (lambda t: t.to(torch.bfloat16) if t.is_floating_point() else t)(torch.as_tensor(a)))
    def _A_setup():
        B, Sq, D = 1, 1, 576
        Hq, Hkv, Sk, Dh = 32, 16, 65536, 128
        assert Hq % Hkv == 0, (Hq, Hkv)
        return {
            "x": _w((lambda *s: torch.randn(*s, dtype=torch.bfloat16) * 0.05)(B, Sq, D)),
            "k_cache": _w((lambda *s: torch.randn(*s, dtype=torch.bfloat16) * 6.4)(B, Hkv, Sk, Dh)),
            "v_cache": _w((lambda *s: torch.randn(*s, dtype=torch.bfloat16) * 0.2)(B, Hkv, Sk, Dh)),
            "wq": _w((lambda *s: torch.randn(*s, dtype=torch.bfloat16) * 6.4)(D, Hq * Dh) * (D ** -0.5)),
            "wo": _w((lambda *s: torch.randn(*s, dtype=torch.bfloat16) * 0.2)(Hq * Dh, D) * ((Hq * Dh) ** -0.5)),
        }
    _A_in = _A_setup()

    def _B_setup():
        B, S, D, F = 1, 1, 576, 4608
        return {
            "x": _w((lambda *s: torch.randn(*s, dtype=torch.bfloat16) * 0.05)(B, S, D)),
            "w_gate": _w((lambda *s: torch.randn(*s, dtype=torch.bfloat16) * 0.05)(D, F)),
            "w_up": _w((lambda *s: torch.randn(*s, dtype=torch.bfloat16) * 0.05)(D, F)),
            "w_down": _w((lambda *s: torch.randn(*s, dtype=torch.bfloat16) * 0.05)(F, D)),
        }
    _B_in = _B_setup()

    return {
        "A_x": _A_in["x"],
        "A_k_cache": _A_in["k_cache"],
        "A_v_cache": _A_in["v_cache"],
        "A_wq": _A_in["wq"],
        "A_wo": _A_in["wo"],
        "B_x": _B_in["x"],
        "B_w_gate": _B_in["w_gate"],
        "B_w_up": _B_in["w_up"],
        "B_w_down": _B_in["w_down"],
        "gate_w": _w((lambda *s: torch.randn(*s, dtype=torch.bfloat16) * 0.1)(576) * 16.0),
    }

def reference(A_x, A_k_cache, A_v_cache, A_wq, A_wo, B_x, B_w_gate, B_w_up, B_w_down, gate_w):
    def _A_ref(x, k_cache, v_cache, wq, wo):
        B, Sq, D = x.shape
        Hq, Dh = 32, 128
        Hkv, Sk = k_cache.shape[1], k_cache.shape[2]
        W = min(4096, max(256, Sk // 4))
        rep = Hq // Hkv
        q = (lambda x, *d: x.permute(*d))((x @ wq).reshape(B, Sq, Hq, Dh), 0, 2, 1, 3)
        k = (lambda x, n, axis: torch.repeat_interleave(x, n, dim=axis))(k_cache[:, :, Sk - W:, :], rep, axis=1)
        v = (lambda x, n, axis: torch.repeat_interleave(x, n, dim=axis))(v_cache[:, :, Sk - W:, :], rep, axis=1)
        scores = torch.einsum("bhqd,bhkd->bhqk", q, k) * (Dh ** -0.5)
        p = _softmax(scores, axis=-1)
        o = torch.einsum("bhqk,bhkd->bhqd", p, v)
        return (lambda x, *d: x.permute(*d))(o, 0, 2, 1, 3).reshape(B, Sq, Hq * Dh) @ wo

    def _B_ref(x, w_gate, w_up, w_down):
        g = _silu(x @ w_gate)
        u = x @ w_up
        return (g * u) @ w_down

    x = A_x
    g = _sigmoid((x * gate_w).sum(-1, keepdims=True))
    a = _A_ref(x, A_k_cache, A_v_cache, A_wq, A_wo)
    b = _B_ref(x, B_w_gate, B_w_up, B_w_down)
    return g * a + (1 - g) * b
```

```asm
; @launch grid=(256,1,1) block=(576,1,1) lds=15232
.amdgcn_target "amdgcn-amd-amdhsa--gfx950"
.text
.p2align 12
.fill 832, 4, 0xbf800000
.globl gated_mix__sliding_block_cached__swiglu_ffn__decode_kernel
.p2align 8
.type gated_mix__sliding_block_cached__swiglu_ffn__decode_kernel,@function
gated_mix__sliding_block_cached__swiglu_ffn__decode_kernel:
    s_cmp_ge_u32 s2, 0x100
    s_cbranch_scc1 L_end
    s_load_dwordx2 s[12:13], s[0:1], 24
    s_load_dwordx2 s[8:9], s[0:1], 0
    s_lshr_b32 s45, s2, 3
    s_cmp_lt_u32 s45, 22
    s_cselect_b32 s49, 8, 48
    s_load_dwordx4 s[64:67], s[0:1], s49
    s_load_dwordx2 s[28:29], s[0:1], 32
    s_load_dwordx2 s[4:5], s[0:1], 64
    s_load_dwordx2 s[32:33], s[0:1], 72
    s_load_dwordx2 s[36:37], s[0:1], 80
    s_load_dwordx2 s[16:17], s[0:1], 96
    v_lshrrev_b32 v18, 6, v0
    v_and_b32 v1, 63, v0
    v_readfirstlane_b32 s3, v18
    s_and_b32 s44, s2, 7
    v_lshrrev_b32 v62, 3, v1
    v_and_b32 v19, 7, v1
    v_lshlrev_b32 v20, 4, v19
    v_lshl_add_u32 v9, v62, 14, v20
    v_lshlrev_b32 v21, 2, v62
    s_bfe_u32 s49, s45, 0x20002
    s_mul_i32 s49, s49, 9
    s_add_u32 s49, s49, s3
    s_lshr_b32 s50, s45, 4
    s_lshl1_add_u32 s50, s44, s50
    s_and_b32 s51, s45, 3
    s_lshl2_add_u32 s50, s50, s51
    s_lshl_b32 s50, s50, 7
    s_lshl_b32 s51, s49, 17
    s_add_u32 s50, s50, s51
    s_add_u32 s51, s50, 8192
    s_lshl_b32 s49, s49, 5
    s_mov_b32 s14, 4718592
    s_mov_b32 s15, 0x20000
    s_movk_i32 s10, 1152
    s_mov_b32 s11, s15
    v_mov_b32 v22, 0
    ds_write_b32 v21, v22 offset:6272
    s_waitcnt lgkmcnt(0)
    buffer_load_dwordx4 v[152:155], v9, s[12:15], s50 offen nt
    buffer_load_dwordx4 v[156:159], v9, s[12:15], s51 offen nt
    buffer_load_dword v11, v21, s[8:11], s49 offen
    s_load_dword s40, s[16:17], 0
    s_load_dwordx2 s[70:71], s[8:9], 0
    s_barrier
    s_mov_b64 s[20:21], s[64:65]
    s_mov_b64 s[24:25], s[66:67]
    s_mov_b32 s23, s15
    v_lshlrev_b32 v8, 4, v1
    s_cmp_ge_u32 s45, 22
    s_cbranch_scc1 L_setF
    s_mov_b32 s22, 0x10000000
    s_mov_b32 s30, s14
    s_cmp_ge_u32 s45, 11
    s_cselect_b32 s49, 1, 0
    s_cselect_b32 s50, 8, 0
    s_lshl1_add_u32 s46, s44, s49
    s_cmp_ge_u32 s45, 19
    s_cselect_b32 s50, 19, s50
    s_sub_u32 s47, s45, s50
    s_min_u32 s49, s47, 2
    s_mul_i32 s50, s47, 94
    s_add_u32 s49, s49, s50
    s_lshr_b32 s50, s47, 2
    s_mul_i32 s50, s50, 6
    s_sub_u32 s49, s49, s50
    s_add_u32 s49, s49, s3
    s_lshl_b32 s49, s49, 10
    s_lshl_b32 s55, s46, 24
    s_add_u32 s55, s55, s49
    s_add_u32 s55, s55, 15728640
    s_movk_i32 s41, 8192
    v_bfe_u32 v18, v1, 2, 2
    v_lshrrev_b32 v19, 4, v1
    v_and_b32 v21, 3, v1
    v_lshlrev_b32 v7, 8, v18
    v_lshl_add_u32 v7, v19, 6, v7
    v_lshl_add_u32 v7, v21, 4, v7
    s_cmp_eq_u32 s3, 8
    s_cselect_b32 s79, 1, 0
    s_branch L_set_done
L_setF:
    s_mov_b32 s22, 5308416
    s_mov_b32 s30, s22
    s_mul_i32 s61, s44, 9
    s_mov_b32 s74, s3
    s_cmp_eq_u32 s45, 31
    s_cbranch_scc0 L_setF1
    s_add_u32 s46, s61, s3
    s_and_b32 s61, s46, 0x78
    s_sub_u32 s61, s61, 6
    s_bfe_u32 s74, s46, 0x20001
    s_add_u32 s74, s74, 5
    s_bitcmp1_b32 s46, 0
    s_cselect_b64 s[20:21], s[66:67], s[64:65]
L_setF1:
    s_add_u32 s61, s61, s45
    s_sub_u32 s61, s61, 22
    s_movk_i32 s49, 9216
    v_mad_u32_u24 v7, v62, s49, v20
    s_mul_i32 s55, s74, 73728
    s_lshl_b32 s49, s61, 7
    s_add_u32 s55, s55, s49
    s_mov_b32 s41, 663552
    s_and_b32 s49, s61, 7
    s_cmp_eq_u32 s49, 3
    s_cselect_b32 s49, s3, 0
    s_cmp_ge_u32 s49, 5
    s_cselect_b32 s77, 1, 0
    s_cmp_eq_u32 s45, 31
    s_cselect_b32 s77, 2, s77
    s_cmp_eq_u32 s77, 1
    s_cselect_b32 s49, 0x40000000, 0
    v_add_u32 v7, s49, v7
    s_mov_b32 s79, 0
L_set_done:
    s_mov_b32 s52, s55
    s_cmp_eq_u32 s79, 1
    s_cbranch_scc1 L_touched
    buffer_load_dwordx4 v[64:67], v7, s[20:23], s52 offen nt
    s_add_u32 s52, s52, s41
    buffer_load_dwordx4 v[68:71], v7, s[20:23], s52 offen nt
    s_add_u32 s52, s52, s41
L_touched:
    s_mov_b64 s[26:27], s[22:23]
    s_mov_b32 s31, s15
    s_mov_b32 s18, 4194304
    s_mov_b32 s19, s15
    v_and_b32 v18, 1, v1
    v_lshlrev_b32 v18, 4, v18
    v_mov_b32 v19, 0xffff
    v_lshlrev_b32 v18, v18, v19
    v_bfe_u32 v19, v1, 1, 2
    v_cmp_eq_u32 s[62:63], 0, v19
    v_cmp_eq_u32 s[64:65], 1, v19
    v_cmp_eq_u32 s[66:67], 2, v19
    v_cmp_eq_u32 s[68:69], 3, v19
    s_mov_b32 s57, 0x01000100
    s_mov_b32 s58, 0x03020302
    v_cndmask_b32 v2, 0, v18, s[62:63]
    v_cndmask_b32 v3, 0, v18, s[64:65]
    v_cndmask_b32 v4, 0, v18, s[66:67]
    v_cndmask_b32 v5, 0, v18, s[68:69]
    v_lshrrev_b32 v18, 5, v1
    v_and_b32 v21, 16, v1
    v_lshl_add_u32 v10, v20, 1, v21
    v_lshl_add_u32 v63, v18, 3, v10
    v_lshl_add_u32 v10, v18, 8, v10
    s_movk_i32 s49, 1152
    v_mad_u32_u24 v6, v62, s49, v20
    s_lshl_b32 s49, s3, 9
    v_add_u32 v20, s49, v10
    s_cmp_eq_u32 s79, 1
    s_cbranch_scc0 L_w1
    s_waitcnt vmcnt(0)
L_w1:
    s_waitcnt vmcnt(2)
    v_perm_b32 v18, v11, v11, s57
    v_perm_b32 v19, v11, v11, s58
    v_and_b32 v32, v18, v2
    v_and_b32 v33, v18, v3
    v_and_b32 v34, v18, v4
    v_and_b32 v35, v18, v5
    v_and_b32 v36, v19, v2
    v_and_b32 v37, v19, v3
    v_and_b32 v38, v19, v4
    v_and_b32 v39, v19, v5
    s_cbranch_scc1 L_w2
    buffer_load_dwordx4 v[72:75], v7, s[20:23], s52 offen nt
    s_add_u32 s52, s52, s41
L_w2:
    v_mov_b32 v23, 1
    v_mfma_f32_16x16x32_bf16 v[40:43], v[32:35], v[152:155], 0
    v_mfma_f32_16x16x32_bf16 v[40:43], v[36:39], v[156:159], v[40:43]
    s_mov_b32 exec_lo, 0xff00ff
    s_mov_b32 exec_hi, 0xff00ff00
    s_waitcnt lgkmcnt(0)
    s_mul_i32 s42, s40, 0x9e3779b1
    s_add_u32 s42, s42, 0x7f4a7c15
    s_mul_i32 s70, s70, 0x85ebca6b
    s_add_u32 s70, s70, s71
    s_mul_hi_u32 s70, s70, 0xc2b2ae35
    s_lshl_b32 s70, s70, 8
    s_xor_b32 s42, s42, s70
    s_lshl_b32 s56, s3, 7
    s_nop 1
    ds_write_b128 v20, v[40:43] offset:0
    s_mov_b64 exec, 1
    ds_add_u32 v22, v23 offset:6272
    s_mov_b64 exec, -1
    s_cmp_lg_u32 s3, 8
    s_cbranch_scc1 L_nopub
    v_lshlrev_b32 v18, 2, v1
    s_lshl_b32 s49, s44, 5
    s_add_u32 s49, s49, s45
    s_lshl_b32 s49, s49, 8
    s_add_u32 s49, s49, 40960
    s_add_u32 s50, s49, 2097152
    v_and_b32 v19, 3, v1
    v_lshlrev_b32 v19, 3, v19
    v_mov_b32 v24, s42
    v_lshrrev_b32 v19, v19, v24
    s_movk_i32 s78, 0xff
L_cnt:
    ds_read_b32 v24, v22 offset:6272
    s_waitcnt lgkmcnt(0)
    v_cmp_ne_u32 vcc, 9, v24
    s_cbranch_vccnz L_cnt
    ds_read2st64_b32 v[112:113], v18 offset0:0 offset1:1
    ds_read2st64_b32 v[114:115], v18 offset0:2 offset1:3
    ds_read2st64_b32 v[116:117], v18 offset0:4 offset1:5
    ds_read2st64_b32 v[118:119], v18 offset0:6 offset1:7
    ds_read2st64_b32 v[120:121], v18 offset0:8 offset1:9
    ds_read2st64_b32 v[122:123], v18 offset0:10 offset1:11
    ds_read2st64_b32 v[124:125], v18 offset0:12 offset1:13
    ds_read2st64_b32 v[126:127], v18 offset0:14 offset1:15
    ds_read2st64_b32 v[128:129], v18 offset0:16 offset1:17
    s_waitcnt lgkmcnt(0)
    v_pk_add_f32 v[112:113], v[112:113], v[114:115]
    v_pk_add_f32 v[116:117], v[116:117], v[118:119]
    v_pk_add_f32 v[120:121], v[120:121], v[122:123]
    v_pk_add_f32 v[124:125], v[124:125], v[126:127]
    v_pk_add_f32 v[112:113], v[112:113], v[116:117]
    v_pk_add_f32 v[120:121], v[120:121], v[124:125]
    v_pk_add_f32 v[112:113], v[112:113], v[120:121]
    v_pk_add_f32 v[112:113], v[112:113], v[128:129]
    v_add_f32 v26, v112, v113
    v_bfi_b32 v26, s78, v19, v26
    buffer_store_dword v26, v18, s[16:19], s50 offen
    buffer_store_dword v26, v18, s[16:19], s49 offen sc1
    s_cmp_lt_u32 s45, 22
    s_cbranch_scc1 L_attn8
L_nopub:
    s_cmp_ge_u32 s45, 22
    s_cbranch_scc1 L_notattn
    buffer_load_dwordx4 v[76:79], v7, s[20:23], s52 offen nt
    s_add_u32 s52, s52, s41
    s_cmp_lt_u32 s47, 2
    s_cselect_b32 s49, 7, 6
    s_and_b32 s50, s47, 3
    s_cmp_eq_u32 s50, 3
    s_cselect_b32 s49, 0, s49
    s_cmp_lt_u32 s3, s49
    s_cselect_b32 s49, 0, 0x40000000
    s_cselect_b32 s53, 0, 0xf149f2ca
    v_add_u32 v60, s49, v7
    v_add_u32 v61, s49, v8
    s_waitcnt vmcnt(3)
    buffer_load_dwordx4 v[80:83], v7, s[20:23], s52 offen nt
    s_add_u32 s52, s52, s41
    s_lshl_b32 s49, s46, 5
    s_add_u32 s49, s49, s47
    s_mul_i32 s49, s49, 9216
    s_add_u32 s56, s56, s49
    s_mul_i32 s59, s46, 11
    s_add_u32 s59, s59, s47
    s_mul_i32 s59, s59, 9
    s_add_u32 s59, s59, s3
    s_lshl_b32 s59, s59, 8
    s_add_u32 s59, s59, 630784
    v_lshrrev_b32 v18, 5, v63
    v_cmp_eq_u32 vcc, s44, v18
    v_lshrrev_b32 v18, 1, v1
    v_and_b32 v18, 16, v18
    v_mov_b32 v14, s42
    v_lshrrev_b32 v14, v18, v14
    s_cmp_eq_u32 s3, 8
    s_cselect_b64 s[72:73], vcc, 0
    s_cmp_eq_u32 s3, s44
    s_cselect_b64 s[72:73], -1, s[72:73]
    s_and_b32 s72, s72, 0x00ff00ff
    s_and_b32 s73, s73, 0x00ff00ff
    v_lshrrev_b32 v15, 8, v14
    s_movk_i32 s78, 0xff
    s_mul_i32 s43, s45, 2
    s_add_u32 s43, s43, s3
    s_sub_u32 s43, s43, 4
    s_mul_i32 s48, s43, 82944
    s_lshl_b32 s49, s44, 7
    s_add_u32 s48, s48, s49
    s_mov_b32 s6, 5308416
    s_mov_b32 s7, s15
    s_cmp_lt_u32 s47, 10
    s_cselect_b32 s49, 0, 0x40000000
    v_add_u32 v13, s49, v6
    v_and_b32 v18, 15, v1
    v_lshrrev_b32 v19, 4, v1
    v_lshlrev_b32 v12, 11, v18
    v_lshl_add_u32 v12, v19, 4, v12
    s_waitcnt vmcnt(3)
    buffer_load_dwordx4 v[84:87], v7, s[20:23], s52 offen nt
    s_add_u32 s52, s52, s41
    s_waitcnt vmcnt(3)
    buffer_load_dwordx4 v[88:91], v7, s[20:23], s52 offen nt
    s_add_u32 s52, s52, s41
    s_waitcnt vmcnt(3)
    buffer_load_dwordx4 v[92:95], v7, s[20:23], s52 offen nt
    s_add_u32 s52, s52, s41
    s_waitcnt vmcnt(3)
    buffer_load_dwordx4 v[96:99], v7, s[20:23], s52 offen nt
    s_add_u32 s52, s52, s41
    s_waitcnt vmcnt(3)
    buffer_load_dwordx4 v[100:103], v7, s[20:23], s52 offen nt
    s_add_u32 s52, s52, s41
    s_waitcnt vmcnt(3)
    buffer_load_dwordx4 v[104:107], v7, s[20:23], s52 offen nt
    s_add_u32 s52, s52, s41
    s_waitcnt vmcnt(3)
    buffer_load_dwordx4 v[108:111], v60, s[20:23], s52 offen nt
    s_mov_b32 s52, s55
    s_waitcnt vmcnt(3)
    buffer_load_dwordx4 v[112:115], v8, s[24:27], s52 offen nt
    s_add_u32 s52, s52, s41
    s_waitcnt vmcnt(3)
    buffer_load_dwordx4 v[116:119], v8, s[24:27], s52 offen nt
    s_add_u32 s52, s52, s41
    s_waitcnt vmcnt(3)
    buffer_load_dwordx4 v[120:123], v8, s[24:27], s52 offen nt
    s_add_u32 s52, s52, s41
    s_waitcnt vmcnt(3)
    buffer_load_dwordx4 v[124:127], v8, s[24:27], s52 offen nt
    s_add_u32 s52, s52, s41
    s_waitcnt vmcnt(3)
    buffer_load_dwordx4 v[128:131], v8, s[24:27], s52 offen nt
    s_add_u32 s52, s52, s41
    s_waitcnt vmcnt(3)
    buffer_load_dwordx4 v[132:135], v8, s[24:27], s52 offen nt
    s_add_u32 s52, s52, s41
    v_and_b32 v18, 0xf0, v7
    v_and_b32 v19, 1, v62
    v_lshl_add_u32 v18, v19, 8, v18
    s_barrier
    ds_read_b128 v[32:35], v18 offset:5376
    s_mov_b32 s60, 0x3e0293ee
    v_lshlrev_b32 v19, 5, v19
    s_lshl_b32 s49, s3, 2
    v_add_u32 v21, s49, v19
    s_waitcnt lgkmcnt(0)
    v_mfma_f32_16x16x32_bf16 v[64:67], v[64:67], v[32:35], 0
    v_mfma_f32_16x16x32_bf16 v[68:71], v[68:71], v[32:35], 0
    v_mfma_f32_16x16x32_bf16 v[72:75], v[72:75], v[32:35], 0
    v_mfma_f32_16x16x32_bf16 v[76:79], v[76:79], v[32:35], 0
    v_mfma_f32_16x16x32_bf16 v[80:83], v[80:83], v[32:35], 0
    v_mfma_f32_16x16x32_bf16 v[84:87], v[84:87], v[32:35], 0
    v_mfma_f32_16x16x32_bf16 v[88:91], v[88:91], v[32:35], 0
    v_mfma_f32_16x16x32_bf16 v[92:95], v[92:95], v[32:35], 0
    v_mfma_f32_16x16x32_bf16 v[96:99], v[96:99], v[32:35], 0
    v_mfma_f32_16x16x32_bf16 v[100:103], v[100:103], v[32:35], 0
    v_mfma_f32_16x16x32_bf16 v[104:107], v[104:107], v[32:35], 0
    v_mfma_f32_16x16x32_bf16 v[108:111], v[108:111], v[32:35], 0
    v_mov_b32_dpp v48, v64 quad_perm:[0,0,0,0] row_mask:0xf bank_mask:0xf
    v_mov_b32_dpp v49, v68 quad_perm:[0,0,0,0] row_mask:0xf bank_mask:0xf
    v_mov_b32_dpp v50, v72 quad_perm:[0,0,0,0] row_mask:0xf bank_mask:0xf
    v_mov_b32_dpp v51, v76 quad_perm:[0,0,0,0] row_mask:0xf bank_mask:0xf
    v_mov_b32_dpp v52, v80 quad_perm:[0,0,0,0] row_mask:0xf bank_mask:0xf
    v_mov_b32_dpp v53, v84 quad_perm:[0,0,0,0] row_mask:0xf bank_mask:0xf
    v_mov_b32_dpp v54, v88 quad_perm:[0,0,0,0] row_mask:0xf bank_mask:0xf
    v_mov_b32_dpp v55, v92 quad_perm:[0,0,0,0] row_mask:0xf bank_mask:0xf
    v_mov_b32_dpp v56, v96 quad_perm:[0,0,0,0] row_mask:0xf bank_mask:0xf
    v_mov_b32_dpp v57, v100 quad_perm:[0,0,0,0] row_mask:0xf bank_mask:0xf
    v_mov_b32_dpp v58, v104 quad_perm:[0,0,0,0] row_mask:0xf bank_mask:0xf
    v_mov_b32_dpp v59, v108 quad_perm:[0,0,0,0] row_mask:0xf bank_mask:0xf
    v_add_f32_dpp v48, v65, v48 quad_perm:[1,1,1,1] row_mask:0xf bank_mask:0xf
    v_add_f32_dpp v49, v69, v49 quad_perm:[1,1,1,1] row_mask:0xf bank_mask:0xf
    v_add_f32_dpp v50, v73, v50 quad_perm:[1,1,1,1] row_mask:0xf bank_mask:0xf
    v_add_f32_dpp v51, v77, v51 quad_perm:[1,1,1,1] row_mask:0xf bank_mask:0xf
    v_add_f32_dpp v52, v81, v52 quad_perm:[1,1,1,1] row_mask:0xf bank_mask:0xf
    v_add_f32_dpp v53, v85, v53 quad_perm:[1,1,1,1] row_mask:0xf bank_mask:0xf
    v_add_f32_dpp v54, v89, v54 quad_perm:[1,1,1,1] row_mask:0xf bank_mask:0xf
    v_add_f32_dpp v55, v93, v55 quad_perm:[1,1,1,1] row_mask:0xf bank_mask:0xf
    v_add_f32_dpp v56, v97, v56 quad_perm:[1,1,1,1] row_mask:0xf bank_mask:0xf
    v_add_f32_dpp v57, v101, v57 quad_perm:[1,1,1,1] row_mask:0xf bank_mask:0xf
    v_add_f32_dpp v58, v105, v58 quad_perm:[1,1,1,1] row_mask:0xf bank_mask:0xf
    v_add_f32_dpp v59, v109, v59 quad_perm:[1,1,1,1] row_mask:0xf bank_mask:0xf
    buffer_load_dwordx4 v[136:139], v8, s[24:27], s52 offen nt
    s_add_u32 s52, s52, s41
    v_add_f32_dpp v48, v66, v48 quad_perm:[2,2,2,2] row_mask:0xf bank_mask:0xf
    v_add_f32_dpp v49, v70, v49 quad_perm:[2,2,2,2] row_mask:0xf bank_mask:0xf
    v_add_f32_dpp v50, v74, v50 quad_perm:[2,2,2,2] row_mask:0xf bank_mask:0xf
    v_add_f32_dpp v51, v78, v51 quad_perm:[2,2,2,2] row_mask:0xf bank_mask:0xf
    v_add_f32_dpp v52, v82, v52 quad_perm:[2,2,2,2] row_mask:0xf bank_mask:0xf
    v_add_f32_dpp v53, v86, v53 quad_perm:[2,2,2,2] row_mask:0xf bank_mask:0xf
    v_add_f32_dpp v54, v90, v54 quad_perm:[2,2,2,2] row_mask:0xf bank_mask:0xf
    v_add_f32_dpp v55, v94, v55 quad_perm:[2,2,2,2] row_mask:0xf bank_mask:0xf
    v_add_f32_dpp v56, v98, v56 quad_perm:[2,2,2,2] row_mask:0xf bank_mask:0xf
    v_add_f32_dpp v57, v102, v57 quad_perm:[2,2,2,2] row_mask:0xf bank_mask:0xf
    v_add_f32_dpp v58, v106, v58 quad_perm:[2,2,2,2] row_mask:0xf bank_mask:0xf
    v_add_f32_dpp v59, v110, v59 quad_perm:[2,2,2,2] row_mask:0xf bank_mask:0xf
    v_add_f32_dpp v48, v67, v48 quad_perm:[3,3,3,3] row_mask:0xf bank_mask:0xf
    v_add_f32_dpp v49, v71, v49 quad_perm:[3,3,3,3] row_mask:0xf bank_mask:0xf
    v_add_f32_dpp v50, v75, v50 quad_perm:[3,3,3,3] row_mask:0xf bank_mask:0xf
    v_add_f32_dpp v51, v79, v51 quad_perm:[3,3,3,3] row_mask:0xf bank_mask:0xf
    v_add_f32_dpp v52, v83, v52 quad_perm:[3,3,3,3] row_mask:0xf bank_mask:0xf
    v_add_f32_dpp v53, v87, v53 quad_perm:[3,3,3,3] row_mask:0xf bank_mask:0xf
    v_add_f32_dpp v54, v91, v54 quad_perm:[3,3,3,3] row_mask:0xf bank_mask:0xf
    v_add_f32_dpp v55, v95, v55 quad_perm:[3,3,3,3] row_mask:0xf bank_mask:0xf
    v_add_f32_dpp v56, v99, v56 quad_perm:[3,3,3,3] row_mask:0xf bank_mask:0xf
    v_add_f32_dpp v57, v103, v57 quad_perm:[3,3,3,3] row_mask:0xf bank_mask:0xf
    v_add_f32_dpp v58, v107, v58 quad_perm:[3,3,3,3] row_mask:0xf bank_mask:0xf
    v_add_f32_dpp v59, v111, v59 quad_perm:[3,3,3,3] row_mask:0xf bank_mask:0xf
    v_add_f32 v59, s53, v59
    v_max3_f32 v18, v48, v49, v50
    v_max3_f32 v18, v18, v51, v52
    v_max3_f32 v18, v18, v53, v54
    v_max3_f32 v18, v18, v55, v56
    v_max3_f32 v18, v18, v57, v58
    v_max_f32 v18, v18, v59
    v_mov_b32 v20, v18
    s_nop 1
    v_permlane16_swap_b32 v18, v20
    s_nop 1
    v_max_f32 v18, v18, v20
    v_mov_b32 v20, v18
    s_nop 1
    v_permlane32_swap_b32 v18, v20
    s_nop 1
    v_max_f32 v18, v18, v20
    s_mov_b32 exec_lo, 0x101
    s_mov_b32 exec_hi, 0x0
    ds_write_b32 v21, v18 offset:5888
    s_mov_b64 exec, -1
    buffer_load_dwordx4 v[140:143], v8, s[24:27], s52 offen nt
    s_add_u32 s52, s52, s41
    s_waitcnt lgkmcnt(0)
    s_barrier
    ds_read_b128 v[32:35], v19 offset:5888
    ds_read_b128 v[36:39], v19 offset:5904
    v_and_b32 v23, 15, v1
    v_lshlrev_b32 v23, 5, v23
    v_and_b32 v24, 16, v1
    v_add_u32 v23, v23, v24
    v_lshrrev_b32 v24, 5, v1
    v_lshl_add_u32 v23, v24, 9, v23
    s_lshl_b32 s49, s3, 10
    v_add_u32 v23, s49, v23
    s_waitcnt lgkmcnt(0)
    v_max3_f32 v18, v32, v33, v34
    v_max3_f32 v18, v18, v35, v36
    v_max3_f32 v18, v18, v37, v38
    v_max_f32 v18, v18, v39
    v_mul_f32 v18, s60, v18
    v_fma_f32 v48, v48, s60, -v18
    v_fma_f32 v49, v49, s60, -v18
    v_fma_f32 v50, v50, s60, -v18
    v_fma_f32 v51, v51, s60, -v18
    v_fma_f32 v52, v52, s60, -v18
    v_fma_f32 v53, v53, s60, -v18
    v_fma_f32 v54, v54, s60, -v18
    v_fma_f32 v55, v55, s60, -v18
    v_fma_f32 v56, v56, s60, -v18
    v_fma_f32 v57, v57, s60, -v18
    v_fma_f32 v58, v58, s60, -v18
    v_fma_f32 v59, v59, s60, -v18
    v_exp_f32 v48, v48
    v_exp_f32 v49, v49
    v_exp_f32 v50, v50
    v_exp_f32 v51, v51
    v_exp_f32 v52, v52
    v_exp_f32 v53, v53
    v_exp_f32 v54, v54
    v_exp_f32 v55, v55
    v_exp_f32 v56, v56
    v_exp_f32 v57, v57
    v_exp_f32 v58, v58
    v_exp_f32 v59, v59
    buffer_load_dwordx4 v[144:147], v8, s[24:27], s52 offen nt
    s_add_u32 s52, s52, s41
    v_add_f32 v22, v48, v49
    v_add_f32 v22, v22, v50
    v_add_f32 v22, v22, v51
    v_add_f32 v22, v22, v52
    v_add_f32 v22, v22, v53
    v_add_f32 v22, v22, v54
    v_add_f32 v22, v22, v55
    v_add_f32 v22, v22, v56
    v_add_f32 v22, v22, v57
    v_add_f32 v22, v22, v58
    v_add_f32 v22, v22, v59
    v_cvt_pk_bf16_f32 v48, v48, v48
    v_cvt_pk_bf16_f32 v49, v49, v49
    v_cvt_pk_bf16_f32 v50, v50, v50
    v_cvt_pk_bf16_f32 v51, v51, v51
    v_cvt_pk_bf16_f32 v52, v52, v52
    v_cvt_pk_bf16_f32 v53, v53, v53
    v_cvt_pk_bf16_f32 v54, v54, v54
    v_cvt_pk_bf16_f32 v55, v55, v55
    v_cvt_pk_bf16_f32 v56, v56, v56
    v_cvt_pk_bf16_f32 v57, v57, v57
    v_cvt_pk_bf16_f32 v58, v58, v58
    v_cvt_pk_bf16_f32 v59, v59, v59
    v_mov_b32 v20, v22
    s_nop 1
    v_permlane16_swap_b32 v22, v20
    s_nop 1
    v_add_f32 v22, v22, v20
    v_mov_b32 v20, v22
    s_nop 1
    v_permlane32_swap_b32 v22, v20
    s_nop 1
    v_add_f32 v22, v22, v20
    s_mov_b32 exec_lo, 0x101
    s_mov_b32 exec_hi, 0x0
    ds_write_b32 v21, v22 offset:5952
    s_mov_b64 exec, -1
    buffer_load_dwordx4 v[148:151], v8, s[24:27], s52 offen nt
    s_add_u32 s52, s52, s41
    v_and_b32 v64, v48, v2
    v_and_b32 v65, v48, v3
    v_and_b32 v66, v48, v4
    v_and_b32 v67, v48, v5
    v_and_b32 v68, v49, v2
    v_and_b32 v69, v49, v3
    v_and_b32 v70, v49, v4
    v_and_b32 v71, v49, v5
    v_and_b32 v72, v50, v2
    v_and_b32 v73, v50, v3
    v_and_b32 v74, v50, v4
    v_and_b32 v75, v50, v5
    v_and_b32 v76, v51, v2
    v_and_b32 v77, v51, v3
    v_and_b32 v78, v51, v4
    v_and_b32 v79, v51, v5
    v_and_b32 v80, v52, v2
    v_and_b32 v81, v52, v3
    v_and_b32 v82, v52, v4
    v_and_b32 v83, v52, v5
    v_and_b32 v84, v53, v2
    v_and_b32 v85, v53, v3
    v_and_b32 v86, v53, v4
    v_and_b32 v87, v53, v5
    v_and_b32 v88, v54, v2
    v_and_b32 v89, v54, v3
    v_and_b32 v90, v54, v4
    v_and_b32 v91, v54, v5
    v_and_b32 v92, v55, v2
    v_and_b32 v93, v55, v3
    v_and_b32 v94, v55, v4
    v_and_b32 v95, v55, v5
    v_and_b32 v96, v56, v2
    v_and_b32 v97, v56, v3
    v_and_b32 v98, v56, v4
    v_and_b32 v99, v56, v5
    v_and_b32 v100, v57, v2
    v_and_b32 v101, v57, v3
    v_and_b32 v102, v57, v4
    v_and_b32 v103, v57, v5
    v_and_b32 v104, v58, v2
    v_and_b32 v105, v58, v3
    v_and_b32 v106, v58, v4
    v_and_b32 v107, v58, v5
    v_and_b32 v108, v59, v2
    v_and_b32 v109, v59, v3
    v_and_b32 v110, v59, v4
    v_and_b32 v111, v59, v5
    s_waitcnt lgkmcnt(0)
    s_barrier
    s_cmp_lt_u32 s3, 6
    s_cbranch_scc1 L_nolse
    s_sub_u32 s49, s3, 6
    s_lshl_b32 s50, s49, 5
    v_mov_b32 v19, s50
    ds_read_b128 v[32:35], v19 offset:5952
    ds_read_b128 v[36:39], v19 offset:5968
    ds_read_b128 v[48:51], v19 offset:5888
    ds_read_b128 v[52:55], v19 offset:5904
    s_lshl_b32 s50, s49, 9
    v_lshl_add_u32 v20, v1, 3, s50
    s_lshl4_add_u32 s75, s46, s47
    s_lshl1_add_u32 s75, s75, s49
    s_lshl_b32 s75, s75, 10
    s_add_u32 s75, s75, 106496
    s_add_u32 s76, s75, 2097152
    s_waitcnt lgkmcnt(0)
    v_pk_add_f32 v[32:33], v[32:33], v[34:35]
    v_pk_add_f32 v[36:37], v[36:37], v[38:39]
    v_max3_f32 v18, v48, v49, v50
    v_pk_add_f32 v[32:33], v[32:33], v[36:37]
    v_max3_f32 v18, v18, v51, v52
    v_add_f32 v32, v32, v33
    v_max3_f32 v18, v18, v53, v54
    v_rcp_f32 v34, v32
    v_log_f32 v36, v32
    v_max_f32 v18, v18, v55
    v_mov_b32 v59, s42
    v_fma_f32 v58, v18, s60, v36
L_nolse:
    v_mfma_f32_16x16x32_bf16 v[40:43], v[64:67], v[112:115], 0
    v_mfma_f32_16x16x32_bf16 v[40:43], v[68:71], v[116:119], v[40:43]
    s_waitcnt vmcnt(7)
    v_mfma_f32_16x16x32_bf16 v[40:43], v[72:75], v[120:123], v[40:43]
    s_waitcnt vmcnt(6)
    v_mfma_f32_16x16x32_bf16 v[40:43], v[76:79], v[124:127], v[40:43]
    s_waitcnt vmcnt(5)
    v_mfma_f32_16x16x32_bf16 v[40:43], v[80:83], v[128:131], v[40:43]
    s_waitcnt vmcnt(4)
    v_mfma_f32_16x16x32_bf16 v[40:43], v[84:87], v[132:135], v[40:43]
    s_waitcnt vmcnt(3)
    v_mfma_f32_16x16x32_bf16 v[40:43], v[88:91], v[136:139], v[40:43]
    buffer_load_dwordx4 v[152:155], v8, s[24:27], s52 offen nt
    s_add_u32 s52, s52, s41
    s_waitcnt vmcnt(3)
    v_mfma_f32_16x16x32_bf16 v[40:43], v[92:95], v[140:143], v[40:43]
    buffer_load_dwordx4 v[156:159], v61, s[24:27], s52 offen nt
    s_waitcnt vmcnt(3)
    v_mfma_f32_16x16x32_bf16 v[40:43], v[96:99], v[144:147], v[40:43]
    buffer_load_dwordx4 v[112:115], v6, s[28:31], s56 offen nt
    s_add_u32 s56, s56, 101376
    s_waitcnt vmcnt(3)
    v_mfma_f32_16x16x32_bf16 v[40:43], v[100:103], v[148:151], v[40:43]
    buffer_load_dwordx4 v[116:119], v6, s[28:31], s56 offen nt
    s_add_u32 s56, s56, 101376
    s_waitcnt vmcnt(3)
    v_mfma_f32_16x16x32_bf16 v[40:43], v[104:107], v[152:155], v[40:43]
    s_waitcnt vmcnt(2)
    v_mfma_f32_16x16x32_bf16 v[40:43], v[108:111], v[156:159], v[40:43]
    s_nop 7
    ds_write_b128 v23, v[40:43] offset:6400
    s_waitcnt lgkmcnt(0)
    s_branch L_barC
.p2align 12
L_attn8:
    s_setprio 3
    s_mov_b32 s79, 0
    s_lshl_b32 s49, s46, 5
    s_add_u32 s49, s49, s47
    s_mul_i32 s49, s49, 9216
    s_add_u32 s56, s56, s49
    s_mul_i32 s59, s46, 11
    s_add_u32 s59, s59, s47
    s_mul_i32 s59, s59, 9
    s_add_u32 s59, s59, s3
    s_lshl_b32 s59, s59, 8
    s_add_u32 s59, s59, 630784
    v_lshrrev_b32 v18, 5, v63
    v_cmp_eq_u32 vcc, s44, v18
    v_lshrrev_b32 v18, 1, v1
    v_and_b32 v18, 16, v18
    v_mov_b32 v14, s42
    v_lshrrev_b32 v14, v18, v14
    s_cmp_eq_u32 s3, 8
    s_cselect_b64 s[72:73], vcc, 0
    s_cmp_eq_u32 s3, s44
    s_cselect_b64 s[72:73], -1, s[72:73]
    s_and_b32 s72, s72, 0x00ff00ff
    s_and_b32 s73, s73, 0x00ff00ff
    v_lshrrev_b32 v15, 8, v14
    s_movk_i32 s78, 0xff
    s_mul_i32 s43, s45, 2
    s_add_u32 s43, s43, s3
    s_sub_u32 s43, s43, 4
    s_mul_i32 s48, s43, 82944
    s_lshl_b32 s49, s44, 7
    s_add_u32 s48, s48, s49
    s_mov_b32 s6, 5308416
    s_mov_b32 s7, s15
    s_cmp_lt_u32 s47, 10
    s_cselect_b32 s49, 0, 0x40000000
    v_add_u32 v13, s49, v6
    v_and_b32 v18, 15, v1
    v_lshrrev_b32 v19, 4, v1
    v_lshlrev_b32 v12, 11, v18
    v_lshl_add_u32 v12, v19, 4, v12
    s_lshl_b32 s51, s46, 12
    s_add_u32 s51, s51, 40960
    s_add_u32 s49, s51, 2097152
    s_mov_b32 s54, 200000
    s_movk_i32 s69, 0xff00
    s_mov_b32 s57, 0x0c0c0400
    s_mov_b32 s58, 0x04000c0c
L_qpoll:
    s_sleep 8
    buffer_load_dwordx4 v[64:67], v8, s[16:19], s49 offen offset:0 sc1
    buffer_load_dwordx4 v[68:71], v8, s[16:19], s49 offen offset:1024 sc1
    buffer_load_dwordx4 v[72:75], v8, s[16:19], s49 offen offset:2048 sc1
    buffer_load_dwordx4 v[76:79], v8, s[16:19], s49 offen offset:3072 sc1
    s_sub_u32 s54, s54, 1
    s_cbranch_scc1 L_qpoll_end
    s_cmp_eq_u32 s54, 199925
    s_cselect_b32 s49, s51, s49
    s_waitcnt vmcnt(0)
    v_perm_b32 v18, v65, v64, s57
    v_perm_b32 v19, v67, v66, s58
    v_or_b32 v18, v18, v19
    v_perm_b32 v20, v69, v68, s57
    v_perm_b32 v21, v71, v70, s58
    v_or_b32 v20, v20, v21
    v_perm_b32 v22, v73, v72, s57
    v_perm_b32 v23, v75, v74, s58
    v_or_b32 v22, v22, v23
    v_perm_b32 v24, v77, v76, s57
    v_perm_b32 v25, v79, v78, s58
    v_or_b32 v24, v24, v25
    v_xor_b32 v18, s42, v18
    v_xor_b32 v20, s42, v20
    v_xor_b32 v22, s42, v22
    v_xor_b32 v24, s42, v24
    v_or3_b32 v18, v18, v20, v22
    v_or_b32 v18, v18, v24
    v_cmp_ne_u32 vcc, 0, v18
    s_cbranch_vccnz L_qpoll
L_qpoll_end:
    v_and_b32 v64, s69, v64
    v_and_b32 v65, s69, v65
    v_and_b32 v66, s69, v66
    v_and_b32 v67, s69, v67
    v_and_b32 v68, s69, v68
    v_and_b32 v69, s69, v69
    v_and_b32 v70, s69, v70
    v_and_b32 v71, s69, v71
    v_and_b32 v72, s69, v72
    v_and_b32 v73, s69, v73
    v_and_b32 v74, s69, v74
    v_and_b32 v75, s69, v75
    v_and_b32 v76, s69, v76
    v_and_b32 v77, s69, v77
    v_and_b32 v78, s69, v78
    v_and_b32 v79, s69, v79
    v_pk_add_f32 v[64:65], v[64:65], v[68:69]
    v_pk_add_f32 v[72:73], v[72:73], v[76:77]
    v_pk_add_f32 v[66:67], v[66:67], v[70:71]
    v_pk_add_f32 v[74:75], v[74:75], v[78:79]
    v_pk_add_f32 v[64:65], v[64:65], v[72:73]
    v_pk_add_f32 v[66:67], v[66:67], v[74:75]
    v_cvt_pk_bf16_f32 v64, v64, v65
    v_cvt_pk_bf16_f32 v65, v66, v67
    v_lshlrev_b32 v18, 3, v1
    ds_write_b64 v18, v[64:65] offset:5376
    s_waitcnt lgkmcnt(0)
    s_barrier
    s_barrier
    buffer_load_dwordx4 v[112:115], v6, s[28:31], s56 offen nt
    s_add_u32 s56, s56, 101376
    buffer_load_dwordx4 v[116:119], v6, s[28:31], s56 offen nt
    s_add_u32 s56, s56, 101376
    s_barrier
    s_branch L_warmT
L_barC:
    s_barrier
    s_cmp_lt_u32 s3, 3
    s_cbranch_scc1 L_ogather
    s_sub_u32 s49, s3, 6
    s_cmp_lt_u32 s49, 2
    s_cbranch_scc0 L_barC2
    ds_read_b64 v[64:65], v20 offset:6400
    ds_read_b64 v[66:67], v20 offset:7424
    ds_read_b64 v[68:69], v20 offset:8448
    ds_read_b64 v[70:71], v20 offset:9472
    ds_read_b64 v[72:73], v20 offset:10496
    ds_read_b64 v[74:75], v20 offset:11520
    ds_read_b64 v[76:77], v20 offset:12544
    ds_read_b64 v[78:79], v20 offset:13568
    s_waitcnt lgkmcnt(4)
    v_pk_add_f32 v[64:65], v[64:65], v[66:67]
    v_pk_add_f32 v[68:69], v[68:69], v[70:71]
    v_pk_add_f32 v[64:65], v[64:65], v[68:69]
    s_waitcnt lgkmcnt(0)
    v_pk_add_f32 v[72:73], v[72:73], v[74:75]
    v_pk_add_f32 v[76:77], v[76:77], v[78:79]
    v_pk_add_f32 v[64:65], v[64:65], v[72:73]
    v_pk_add_f32 v[64:65], v[64:65], v[76:77]
    v_mul_f32 v56, v64, v34
    v_mul_f32 v57, v65, v34
    buffer_store_dwordx4 v[56:59], v8, s[16:19], s76 offen
    s_barrier
    buffer_load_dwordx4 v[120:123], v13, s[28:31], s56 offen nt
    buffer_store_dwordx4 v[56:59], v8, s[16:19], s75 offen sc1
    s_mov_b32 s79, 1
    s_branch L_barD0
L_barC2:
    s_sub_u32 s49, s3, 4
    s_cmp_lt_u32 s49, 2
    s_cbranch_scc0 L_barC3
    s_mul_i32 s40, s43, 288
    s_add_u32 s40, s40, 22528
    s_movk_i32 s69, 0xff00
    s_mov_b32 s57, 0x0c0c0400
    s_mov_b32 s58, 0x04000c0c
    s_mul_i32 s51, s3, 288
    v_add_u32 v24, s51, v8
    v_lshl_add_u32 v25, v62, 2, s51
    s_mov_b32 s79, 2
    s_barrier
    buffer_load_dwordx4 v[120:123], v13, s[28:31], s56 offen nt
    s_barrier
    s_mov_b32 exec_lo, 0x3ffff
    s_mov_b32 exec_hi, 0x0
    buffer_load_dwordx4 v[92:95], v8, s[16:19], s40 offen sc1
    s_mov_b64 exec, -1
    buffer_load_dwordx4 v[124:127], v6, s[4:7], s48 offen nt
    s_add_u32 s48, s48, 9216
    buffer_load_dwordx4 v[128:131], v6, s[4:7], s48 offen nt
    s_add_u32 s48, s48, 9216
    buffer_load_dwordx4 v[132:135], v6, s[4:7], s48 offen nt
    s_add_u32 s48, s48, 9216
    buffer_load_dwordx4 v[136:139], v6, s[4:7], s48 offen nt
    s_add_u32 s48, s48, 9216
    buffer_load_dwordx4 v[140:143], v6, s[4:7], s48 offen nt
    s_add_u32 s48, s48, 9216
    buffer_load_dwordx4 v[144:147], v6, s[4:7], s48 offen nt
    s_add_u32 s48, s48, 9216
    buffer_load_dwordx4 v[148:151], v6, s[4:7], s48 offen nt
    s_add_u32 s48, s48, 9216
    buffer_load_dwordx4 v[152:155], v6, s[4:7], s48 offen nt
    s_add_u32 s48, s48, 9216
    buffer_load_dwordx4 v[156:159], v6, s[4:7], s48 offen nt
    s_branch L_barD
L_barC3:
    s_barrier
    buffer_load_dwordx4 v[120:123], v13, s[28:31], s56 offen nt
L_barD0:
    s_barrier
    s_branch L_barD
L_ogather:
    s_mul_i32 s49, s3, 11
    s_add_u32 s49, s49, s47
    s_lshl_b32 s50, s46, 15
    s_lshl_b32 s51, s49, 6
    s_add_u32 s50, s50, s51
    s_add_u32 s51, s50, 106496
    s_add_u32 s50, s51, 2097152
    v_mov_b32 v32, 0
    v_mov_b32 v33, 0
    v_mov_b32 v34, 0xf149f2ca
    v_lshrrev_b32 v19, 4, v1
    s_lshl_b32 s75, s3, 5
    v_lshl_add_u32 v21, v19, 3, s75
    s_mov_b32 s54, 200000
    s_cmp_ge_u32 s49, 32
    s_cbranch_scc0 L_op0
    s_barrier
    buffer_load_dwordx4 v[120:123], v13, s[28:31], s56 offen nt
    s_barrier
    s_branch L_owrite
L_op0:
    s_mov_b32 exec_lo, 0x7ff07ff
    s_mov_b32 exec_hi, 0x7ff07ff
    s_setprio 3
    s_barrier
    buffer_load_dwordx4 v[32:35], v12, s[16:19], s50 offen sc1
    s_mov_b64 exec, -1
    buffer_load_dwordx4 v[120:123], v13, s[28:31], s56 offen nt
    s_mov_b32 exec_lo, 0x7ff07ff
    s_mov_b32 exec_hi, 0x7ff07ff
    s_waitcnt vmcnt(1)
    v_cmpx_ne_u32 vcc, s42, v35
    s_cbranch_execz L_opoll_end
L_opoll:
    buffer_load_dwordx4 v[32:35], v12, s[16:19], s50 offen sc1
    s_sub_u32 s54, s54, 1
    s_cbranch_scc1 L_opoll_end
    s_cmp_eq_u32 s54, 199700
    s_cselect_b32 s50, s51, s50
    s_waitcnt vmcnt(0)
    v_cmpx_ne_u32 vcc, s42, v35
    s_cbranch_execnz L_opoll
L_opoll_end:
    s_barrier
    s_mov_b64 exec, -1
    v_mov_b32 v22, v34
    s_nop 1
    s_nop 1
    v_max_f32_dpp v22, v22, v22 row_ror:8 row_mask:0xf bank_mask:0xf
    s_nop 1
    v_max_f32_dpp v22, v22, v22 row_ror:4 row_mask:0xf bank_mask:0xf
    s_nop 1
    v_max_f32_dpp v22, v22, v22 row_ror:2 row_mask:0xf bank_mask:0xf
    s_nop 1
    v_max_f32_dpp v22, v22, v22 row_ror:1 row_mask:0xf bank_mask:0xf
    v_sub_f32 v34, v34, v22
    v_exp_f32 v34, v34
    s_nop 0
    v_mul_f32 v32, v32, v34
    v_mul_f32 v33, v33, v34
    s_nop 0
    v_add_f32_dpp v34, v34, v34 row_ror:8 row_mask:0xf bank_mask:0xf
    v_add_f32_dpp v32, v32, v32 row_ror:8 row_mask:0xf bank_mask:0xf
    v_add_f32_dpp v33, v33, v33 row_ror:8 row_mask:0xf bank_mask:0xf
    v_add_f32_dpp v34, v34, v34 row_ror:4 row_mask:0xf bank_mask:0xf
    v_add_f32_dpp v32, v32, v32 row_ror:4 row_mask:0xf bank_mask:0xf
    v_add_f32_dpp v33, v33, v33 row_ror:4 row_mask:0xf bank_mask:0xf
    v_add_f32_dpp v34, v34, v34 row_ror:2 row_mask:0xf bank_mask:0xf
    v_add_f32_dpp v32, v32, v32 row_ror:2 row_mask:0xf bank_mask:0xf
    v_add_f32_dpp v33, v33, v33 row_ror:2 row_mask:0xf bank_mask:0xf
    v_add_f32_dpp v34, v34, v34 row_ror:1 row_mask:0xf bank_mask:0xf
    v_add_f32_dpp v32, v32, v32 row_ror:1 row_mask:0xf bank_mask:0xf
    v_add_f32_dpp v33, v33, v33 row_ror:1 row_mask:0xf bank_mask:0xf
    v_rcp_f32 v34, v34
    s_nop 0
    v_mul_f32 v32, v32, v34
    v_mul_f32 v33, v33, v34
    v_cvt_pk_bf16_f32 v32, v32, v32
    v_cvt_pk_bf16_f32 v33, v33, v33
    s_branch L_owrite
L_warmT:
    s_branch L_barC
L_owrite:
    s_mov_b32 exec_lo, 0x10001
    s_mov_b32 exec_hi, 0x10001
    ds_write_b64 v21, v[32:33] offset:6080
    s_mov_b64 exec, -1
L_barD:
    v_lshlrev_b32 v18, 2, v62
    s_waitcnt lgkmcnt(0)
    s_barrier
    ds_read_b32 v48, v18 offset:6080
    ds_read_b32 v49, v18 offset:6112
    ds_read_b32 v50, v18 offset:6144
    s_cmp_eq_u32 s79, 2
    s_waitcnt lgkmcnt(0)
    v_and_b32 v64, v48, v2
    v_and_b32 v65, v48, v3
    v_and_b32 v66, v48, v4
    v_and_b32 v67, v48, v5
    v_and_b32 v68, v49, v2
    v_and_b32 v69, v49, v3
    v_and_b32 v70, v49, v4
    v_and_b32 v71, v49, v5
    v_and_b32 v72, v50, v2
    v_and_b32 v73, v50, v3
    v_and_b32 v74, v50, v4
    v_and_b32 v75, v50, v5
    s_waitcnt vmcnt(10)
    s_cbranch_scc1 L_wo
    s_cmp_eq_u32 s79, 1
    s_waitcnt vmcnt(1)
    s_cbranch_scc1 L_wo
    s_waitcnt vmcnt(0)
L_wo:
    v_mfma_f32_16x16x32_bf16 v[44:47], v[64:67], v[112:115], 0
    v_mfma_f32_16x16x32_bf16 v[44:47], v[68:71], v[116:119], v[44:47]
    v_mfma_f32_16x16x32_bf16 v[44:47], v[72:75], v[120:123], v[44:47]
    s_add_u32 s49, s59, 2097152
    s_nop 6
    v_permlane32_swap_b32 v44, v46
    v_permlane32_swap_b32 v45, v47
    s_nop 0
    v_add_f32_dpp v44, v46, v44 row_ror:8 row_mask:0xf bank_mask:0xf
    v_add_f32_dpp v45, v47, v45 row_ror:8 row_mask:0xf bank_mask:0xf
    v_bfi_b32 v44, s78, v14, v44
    v_bfi_b32 v45, s78, v15, v45
    s_mov_b64 exec, s[72:73]
    s_cbranch_execz L_na1
    buffer_store_dwordx2 v[44:45], v63, s[16:19], s49 offen
L_na1:
    s_mov_b32 exec_lo, 0xff00ff
    s_mov_b32 exec_hi, 0xff00ff
    buffer_store_dwordx2 v[44:45], v63, s[16:19], s59 offen sc1
    s_mov_b64 exec, -1
    s_cmp_eq_u32 s79, 2
    s_cbranch_scc0 L_aend
    s_waitcnt vmcnt(10)
    s_mov_b32 s54, 200000
    s_mov_b32 exec_lo, 0x3ffff
    s_mov_b32 exec_hi, 0x0
    s_branch L_hca
L_hga:
    s_sub_u32 s54, s54, 1
    s_cbranch_scc1 L_hgea
    s_sleep 4
    buffer_load_dwordx4 v[92:95], v8, s[16:19], s40 offen sc1
    s_waitcnt vmcnt(0)
L_hca:
    v_perm_b32 v22, v93, v92, s57
    v_perm_b32 v23, v95, v94, s58
    v_or_b32 v22, v22, v23
    v_cmp_ne_u32 vcc, s42, v22
    s_cbranch_vccnz L_hga
L_hgea:
    s_mov_b32 s50, 0x03020302
    v_perm_b32 v92, v92, v92, s50
    v_perm_b32 v93, v93, v93, s50
    v_perm_b32 v94, v94, v94, s50
    v_perm_b32 v95, v95, v95, s50
    ds_write_b128 v24, v[92:95] offset:0
    s_mov_b64 exec, -1
    ds_read2_b32 v[80:81], v25 offset0:0 offset1:8
    ds_read2_b32 v[82:83], v25 offset0:16 offset1:24
    ds_read2_b32 v[84:85], v25 offset0:32 offset1:40
    ds_read2_b32 v[86:87], v25 offset0:48 offset1:56
    ds_read_b32 v88, v25 offset:256
    s_add_u32 s59, s43, 176
    s_mul_i32 s59, s59, 9
    s_add_u32 s59, s59, s44
    s_lshl_b32 s59, s59, 8
    s_add_u32 s59, s59, 630784
    s_mov_b32 s72, 0x00ff00ff
    s_mov_b32 s73, s72
    s_waitcnt lgkmcnt(0)
    v_and_b32 v32, v80, v2
    v_and_b32 v33, v80, v3
    v_and_b32 v34, v80, v4
    v_and_b32 v35, v80, v5
    s_waitcnt vmcnt(9)
    s_nop 0
    v_mfma_f32_16x16x32_bf16 v[40:43], v[32:35], v[124:127], 0
    v_and_b32 v36, v81, v2
    v_and_b32 v37, v81, v3
    v_and_b32 v38, v81, v4
    v_and_b32 v39, v81, v5
    s_waitcnt vmcnt(8)
    s_nop 0
    v_mfma_f32_16x16x32_bf16 v[40:43], v[36:39], v[128:131], v[40:43]
    v_and_b32 v32, v82, v2
    v_and_b32 v33, v82, v3
    v_and_b32 v34, v82, v4
    v_and_b32 v35, v82, v5
    s_waitcnt vmcnt(7)
    s_nop 0
    v_mfma_f32_16x16x32_bf16 v[40:43], v[32:35], v[132:135], v[40:43]
    v_and_b32 v36, v83, v2
    v_and_b32 v37, v83, v3
    v_and_b32 v38, v83, v4
    v_and_b32 v39, v83, v5
    s_waitcnt vmcnt(6)
    s_nop 0
    v_mfma_f32_16x16x32_bf16 v[40:43], v[36:39], v[136:139], v[40:43]
    v_and_b32 v32, v84, v2
    v_and_b32 v33, v84, v3
    v_and_b32 v34, v84, v4
    v_and_b32 v35, v84, v5
    s_waitcnt vmcnt(5)
    s_nop 0
    v_mfma_f32_16x16x32_bf16 v[40:43], v[32:35], v[140:143], v[40:43]
    v_and_b32 v36, v85, v2
    v_and_b32 v37, v85, v3
    v_and_b32 v38, v85, v4
    v_and_b32 v39, v85, v5
    s_waitcnt vmcnt(4)
    s_nop 0
    v_mfma_f32_16x16x32_bf16 v[40:43], v[36:39], v[144:147], v[40:43]
    v_and_b32 v32, v86, v2
    v_and_b32 v33, v86, v3
    v_and_b32 v34, v86, v4
    v_and_b32 v35, v86, v5
    s_waitcnt vmcnt(3)
    s_nop 0
    v_mfma_f32_16x16x32_bf16 v[40:43], v[32:35], v[148:151], v[40:43]
    v_and_b32 v36, v87, v2
    v_and_b32 v37, v87, v3
    v_and_b32 v38, v87, v4
    v_and_b32 v39, v87, v5
    s_waitcnt vmcnt(2)
    s_nop 0
    v_mfma_f32_16x16x32_bf16 v[40:43], v[36:39], v[152:155], v[40:43]
    v_and_b32 v32, v88, v2
    v_and_b32 v33, v88, v3
    v_and_b32 v34, v88, v4
    v_and_b32 v35, v88, v5
    s_waitcnt vmcnt(1)
    s_nop 0
    v_mfma_f32_16x16x32_bf16 v[40:43], v[32:35], v[156:159], v[40:43]
    s_add_u32 s49, s59, 2097152
    s_nop 6
    v_permlane32_swap_b32 v40, v42
    v_permlane32_swap_b32 v41, v43
    s_nop 0
    v_add_f32_dpp v40, v42, v40 row_ror:8 row_mask:0xf bank_mask:0xf
    v_add_f32_dpp v41, v43, v41 row_ror:8 row_mask:0xf bank_mask:0xf
    v_bfi_b32 v40, s78, v14, v40
    v_bfi_b32 v41, s78, v15, v41
    s_mov_b64 exec, s[72:73]
    s_cbranch_execz L_na2
    buffer_store_dwordx2 v[40:41], v63, s[16:19], s49 offen
L_na2:
    s_mov_b32 exec_lo, 0xff00ff
    s_mov_b32 exec_hi, 0xff00ff
    buffer_store_dwordx2 v[40:41], v63, s[16:19], s59 offen sc1
    s_mov_b64 exec, -1
    s_cmp_lt_u32 s45, 22
    s_cbranch_scc0 L_fds2
L_aend:
    s_endpgm
.p2align 12
L_notattn:
    v_and_b32 v19, 7, v1
    v_mad_u32_u24 v18, v62, 64, v19
    v_lshl_add_u32 v18, v62, 3, v18
    v_lshlrev_b32 v18, 1, v18
    s_lshl_b32 s49, s74, 4
    s_mov_b64 s[34:35], s[10:11]
    s_mov_b64 s[38:39], s[10:11]
    buffer_load_ushort v16, v18, s[8:11], s49 offen
    buffer_load_ushort v17, v18, s[32:35], s49 offen
    s_cmp_eq_u32 s77, 2
    s_cselect_b32 s49, 0x40000000, 0
    v_or_b32 v12, s49, v7
    s_mul_i32 s56, s61, 73728
    s_add_u32 s56, s56, 1024
    s_add_u32 s59, s61, 176
    s_mul_i32 s59, s59, 9
    s_add_u32 s59, s59, 8
    s_lshl_b32 s59, s59, 8
    s_add_u32 s59, s59, 630784
    v_lshrrev_b32 v18, 5, v63
    v_cmp_eq_u32 vcc, s44, v18
    v_lshrrev_b32 v18, 1, v1
    v_and_b32 v18, 16, v18
    v_mov_b32 v14, s42
    v_lshrrev_b32 v14, v18, v14
    s_cmp_eq_u32 8, 8
    s_cselect_b64 s[72:73], vcc, 0
    s_cmp_eq_u32 8, s44
    s_cselect_b64 s[72:73], -1, s[72:73]
    s_and_b32 s72, s72, 0x00ff00ff
    s_and_b32 s73, s73, 0x00ff00ff
    v_lshrrev_b32 v15, 8, v14
    s_movk_i32 s78, 0xff
    s_mul_i32 s43, s45, 2
    s_add_u32 s43, s43, s3
    s_sub_u32 s43, s43, 0
    s_cmp_eq_u32 s45, 31
    s_cselect_b32 s47, 2, 2
    s_mul_i32 s48, s43, 82944
    s_lshl_b32 s49, s44, 7
    s_add_u32 s48, s48, s49
    s_mov_b32 s6, 5308416
    s_mov_b32 s7, s15
    s_waitcnt vmcnt(4)
    buffer_load_dwordx4 v[76:79], v7, s[20:23], s52 offen nt
    s_add_u32 s52, s52, s41
    s_waitcnt vmcnt(4)
    buffer_load_dwordx4 v[80:83], v7, s[20:23], s52 offen nt
    s_add_u32 s52, s52, s41
    s_waitcnt vmcnt(4)
    buffer_load_dwordx4 v[84:87], v7, s[20:23], s52 offen nt
    s_add_u32 s52, s52, s41
    s_waitcnt vmcnt(3)
    v_lshl_or_b32 v22, v16, 16, v16
    v_lshlrev_b32 v23, 2, v62
    ds_bpermute_b32 v48, v23, v22 offset:0
    ds_bpermute_b32 v49, v23, v22 offset:32
    ds_bpermute_b32 v50, v23, v22 offset:64
    ds_bpermute_b32 v51, v23, v22 offset:96
    ds_bpermute_b32 v52, v23, v22 offset:128
    ds_bpermute_b32 v53, v23, v22 offset:160
    ds_bpermute_b32 v54, v23, v22 offset:192
    ds_bpermute_b32 v55, v23, v22 offset:224
    v_lshlrev_b32 v16, 16, v16
    v_lshlrev_b32 v17, 16, v17
    v_mul_f32 v16, v16, v17
    v_cvt_pk_bf16_f32 v16, v16, v16
    v_and_b32 v16, 0xffff0000, v16
    s_nop 1
    v_add_f32_dpp v16, v16, v16 row_ror:8 row_mask:0xf bank_mask:0xf
    s_nop 1
    v_add_f32_dpp v16, v16, v16 row_ror:4 row_mask:0xf bank_mask:0xf
    s_nop 1
    v_add_f32_dpp v16, v16, v16 row_ror:2 row_mask:0xf bank_mask:0xf
    s_nop 1
    v_add_f32_dpp v16, v16, v16 row_ror:1 row_mask:0xf bank_mask:0xf
    v_mov_b32 v18, v16
    s_nop 1
    v_permlane16_swap_b32 v16, v18
    s_nop 1
    v_add_f32 v16, v16, v18
    v_mov_b32 v18, v16
    s_nop 1
    v_permlane32_swap_b32 v16, v18
    s_nop 1
    v_add_f32 v16, v16, v18
    s_lshl_b32 s49, s3, 2
    v_mov_b32 v21, s49
    s_mov_b64 exec, 1
    ds_write_b32 v21, v16 offset:6016
    s_mov_b64 exec, -1
    s_waitcnt lgkmcnt(0)
    v_and_b32 v18, 31, v1
    v_lshrrev_b32 v19, 5, v1
    v_mul_u32_u24 v61, 2304, v18
    v_lshl_add_u32 v61, v19, 4, v61
    s_lshl3_add_u32 s60, s44, s45
    s_sub_u32 s60, s60, 22
    s_add_u32 s50, s44, 64
    s_cmp_eq_u32 s45, 30
    s_cselect_b32 s60, s50, s60
    s_mul_i32 s53, s3, 73728
    s_lshl_b32 s50, s60, 5
    s_add_u32 s53, s53, s50
    s_add_u32 s53, s53, 630784
    s_lshl_b32 s51, s3, 5
    v_add_u32 v28, s51, v18
    s_movk_i32 s75, 240
    s_cmp_eq_u32 s45, 30
    s_cselect_b32 s75, 248, s75
    s_cselect_b32 s76, 9, 64
    s_cselect_b32 s50, s44, 0
    v_cmp_gt_u32 s[62:63], s75, v28
    v_lshlrev_b32 v9, 1, v28
    v_lshl_add_u32 v9, v19, 4, v9
    s_mul_i32 s51, s44, 22
    s_mul_i32 s75, s50, 9
    s_add_u32 s75, s75, 176
    v_subrev_u32 v29, s51, v28
    v_subrev_u32 v30, s75, v28
    v_cmp_gt_u32 s[64:65], 22, v29
    v_cmp_gt_u32 vcc, s76, v30
    v_mov_b32 v22, 2097152
    s_or_b64 vcc, s[64:65], vcc
    s_movk_i32 s69, 0xff00
    s_mov_b32 s57, 0x0c0c0400
    s_mov_b32 s58, 0x04000c0c
    v_cndmask_b32 v60, 0, v22, vcc
    v_add_u32 v60, v60, v61
    s_cmp_eq_u32 s77, 1
    s_cbranch_scc0 L_m0
    s_lshl_b32 s49, s3, 9
    s_and_b32 s50, s61, 0x78
    s_lshl1_add_u32 s50, s3, s50
    s_lshl_b32 s50, s50, 8
    s_add_u32 s50, s50, 1536
    v_add_u32 v21, s49, v8
    s_mov_b32 s54, 200000
    s_movk_i32 s69, 0xff00
    s_mov_b32 s57, 0x0c0c0400
    s_mov_b32 s58, 0x04000c0c
    s_mov_b32 exec_hi, 0
L_hpoll:
    s_sleep 4
    buffer_load_dwordx4 v[32:35], v8, s[16:19], s50 offen sc1
    s_sub_u32 s54, s54, 1
    s_cbranch_scc1 L_hpoll_end
    s_waitcnt vmcnt(0)
    v_perm_b32 v22, v33, v32, s57
    v_perm_b32 v23, v35, v34, s58
    v_or_b32 v22, v22, v23
    v_cmp_ne_u32 vcc, s42, v22
    s_cbranch_vccnz L_hpoll
L_hpoll_end:
    v_and_b32 v32, s69, v32
    v_and_b32 v33, s69, v33
    v_and_b32 v34, s69, v34
    v_and_b32 v35, s69, v35
    ds_write_b128 v21, v[32:35] offset:6400
    s_mov_b64 exec, -1
    s_branch L_barE
L_m0:
    v_and_b32 v32, v48, v2
    v_and_b32 v33, v48, v3
    v_and_b32 v34, v48, v4
    v_and_b32 v35, v48, v5
    s_nop 1
    v_mfma_f32_16x16x32_bf16 v[40:43], v[32:35], v[64:67], 0
    v_and_b32 v36, v49, v2
    v_and_b32 v37, v49, v3
    v_and_b32 v38, v49, v4
    v_and_b32 v39, v49, v5
    s_nop 1
    v_mfma_f32_16x16x32_bf16 v[40:43], v[36:39], v[68:71], v[40:43]
    v_and_b32 v32, v50, v2
    v_and_b32 v33, v50, v3
    v_and_b32 v34, v50, v4
    v_and_b32 v35, v50, v5
    s_nop 1
    v_mfma_f32_16x16x32_bf16 v[40:43], v[32:35], v[72:75], v[40:43]
    v_and_b32 v36, v51, v2
    v_and_b32 v37, v51, v3
    v_and_b32 v38, v51, v4
    v_and_b32 v39, v51, v5
    s_waitcnt vmcnt(2)
    s_nop 0
    v_mfma_f32_16x16x32_bf16 v[40:43], v[36:39], v[76:79], v[40:43]
    v_and_b32 v32, v52, v2
    v_and_b32 v33, v52, v3
    v_and_b32 v34, v52, v4
    v_and_b32 v35, v52, v5
    s_waitcnt vmcnt(1)
    buffer_load_dwordx4 v[88:91], v7, s[20:23], s52 offen nt
    s_add_u32 s52, s52, s41
    v_mfma_f32_16x16x32_bf16 v[40:43], v[32:35], v[80:83], v[40:43]
    v_and_b32 v36, v53, v2
    v_and_b32 v37, v53, v3
    v_and_b32 v38, v53, v4
    v_and_b32 v39, v53, v5
    s_waitcnt vmcnt(1)
    buffer_load_dwordx4 v[92:95], v7, s[20:23], s52 offen nt
    s_mov_b32 s52, s55
    v_mfma_f32_16x16x32_bf16 v[40:43], v[36:39], v[84:87], v[40:43]
    v_and_b32 v32, v54, v2
    v_and_b32 v33, v54, v3
    v_and_b32 v34, v54, v4
    v_and_b32 v35, v54, v5
    s_waitcnt vmcnt(1)
    buffer_load_dwordx4 v[96:99], v12, s[24:27], s52 offen nt
    s_add_u32 s52, s52, s41
    v_mfma_f32_16x16x32_bf16 v[40:43], v[32:35], v[88:91], v[40:43]
    v_and_b32 v36, v55, v2
    v_and_b32 v37, v55, v3
    v_and_b32 v38, v55, v4
    v_and_b32 v39, v55, v5
    s_waitcnt vmcnt(1)
    buffer_load_dwordx4 v[100:103], v12, s[24:27], s52 offen nt
    s_add_u32 s52, s52, s41
    v_mfma_f32_16x16x32_bf16 v[40:43], v[36:39], v[92:95], v[40:43]
    s_cmp_eq_u32 s77, 2
    s_cbranch_scc0 L_nohelp
    s_lshl_b32 s59, s46, 8
    s_add_u32 s59, s59, 4096
    s_add_u32 s49, s59, 2097152
    s_nop 6
    v_permlane32_swap_b32 v40, v42
    v_permlane32_swap_b32 v41, v43
    s_nop 0
    v_add_f32_dpp v40, v42, v40 row_ror:8 row_mask:0xf bank_mask:0xf
    v_add_f32_dpp v41, v43, v41 row_ror:8 row_mask:0xf bank_mask:0xf
    v_bfi_b32 v40, s78, v14, v40
    v_bfi_b32 v41, s78, v15, v41
    s_mov_b32 exec_lo, 0xff00ff
    s_mov_b32 exec_hi, 0xff00ff
    buffer_store_dwordx2 v[40:41], v63, s[16:19], s59 offen sc1
    s_mov_b64 exec, -1
    s_branch L_hw
L_nohelp:
    v_and_b32 v32, v48, v2
    v_and_b32 v33, v48, v3
    v_and_b32 v34, v48, v4
    v_and_b32 v35, v48, v5
    s_waitcnt vmcnt(1)
    buffer_load_dwordx4 v[104:107], v12, s[24:27], s52 offen nt
    s_add_u32 s52, s52, s41
    buffer_load_dwordx4 v[108:111], v12, s[24:27], s52 offen nt
    s_add_u32 s52, s52, s41
    v_mfma_f32_16x16x32_bf16 v[44:47], v[32:35], v[96:99], 0
    v_and_b32 v36, v49, v2
    v_and_b32 v37, v49, v3
    v_and_b32 v38, v49, v4
    v_and_b32 v39, v49, v5
    s_waitcnt vmcnt(2)
    buffer_load_dwordx4 v[112:115], v12, s[24:27], s52 offen nt
    s_add_u32 s52, s52, s41
    v_mfma_f32_16x16x32_bf16 v[44:47], v[36:39], v[100:103], v[44:47]
    v_and_b32 v32, v50, v2
    v_and_b32 v33, v50, v3
    v_and_b32 v34, v50, v4
    v_and_b32 v35, v50, v5
    s_waitcnt vmcnt(2)
    buffer_load_dwordx4 v[116:119], v12, s[24:27], s52 offen nt
    s_add_u32 s52, s52, s41
    v_mfma_f32_16x16x32_bf16 v[44:47], v[32:35], v[104:107], v[44:47]
    v_and_b32 v36, v51, v2
    v_and_b32 v37, v51, v3
    v_and_b32 v38, v51, v4
    v_and_b32 v39, v51, v5
    s_waitcnt vmcnt(2)
    buffer_load_dwordx4 v[120:123], v12, s[24:27], s52 offen nt
    s_add_u32 s52, s52, s41
    v_mfma_f32_16x16x32_bf16 v[44:47], v[36:39], v[108:111], v[44:47]
    v_and_b32 v32, v52, v2
    v_and_b32 v33, v52, v3
    v_and_b32 v34, v52, v4
    v_and_b32 v35, v52, v5
    s_waitcnt vmcnt(2)
    buffer_load_dwordx4 v[124:127], v12, s[24:27], s52 offen nt
    v_mfma_f32_16x16x32_bf16 v[44:47], v[32:35], v[112:115], v[44:47]
    v_and_b32 v36, v53, v2
    v_and_b32 v37, v53, v3
    v_and_b32 v38, v53, v4
    v_and_b32 v39, v53, v5
    s_waitcnt vmcnt(2)
    s_nop 0
    v_mfma_f32_16x16x32_bf16 v[44:47], v[36:39], v[116:119], v[44:47]
    v_and_b32 v32, v54, v2
    v_and_b32 v33, v54, v3
    v_and_b32 v34, v54, v4
    v_and_b32 v35, v54, v5
    s_waitcnt vmcnt(1)
    s_nop 0
    v_mfma_f32_16x16x32_bf16 v[44:47], v[32:35], v[120:123], v[44:47]
    v_and_b32 v36, v55, v2
    v_and_b32 v37, v55, v3
    v_and_b32 v38, v55, v4
    v_and_b32 v39, v55, v5
    s_waitcnt vmcnt(0)
    s_nop 0
    v_mfma_f32_16x16x32_bf16 v[44:47], v[36:39], v[124:127], v[44:47]
    s_nop 1
    s_lshl_b32 s49, s3, 9
    v_add_u32 v20, s49, v63
    v_permlane32_swap_b32 v40, v42
    v_permlane32_swap_b32 v41, v43
    s_nop 1
    v_add_f32_dpp v40, v42, v40 row_ror:8 row_mask:0xf bank_mask:0xf
    v_add_f32_dpp v41, v43, v41 row_ror:8 row_mask:0xf bank_mask:0xf
    v_permlane32_swap_b32 v44, v46
    v_permlane32_swap_b32 v45, v47
    s_nop 0
    v_add_f32_dpp v44, v46, v44 row_ror:8 row_mask:0xf bank_mask:0xf
    v_add_f32_dpp v45, v47, v45 row_ror:8 row_mask:0xf bank_mask:0xf
    s_mov_b32 exec_lo, 0xff00ff
    s_mov_b32 exec_hi, 0xff00ff
    ds_write_b64 v20, v[40:41] offset:6400
    ds_write_b64 v20, v[44:45] offset:6656
    s_mov_b64 exec, -1
L_barE:
    s_cmp_eq_u32 s3, 7
    s_cbranch_scc1 L_h7
    s_waitcnt lgkmcnt(0)
    s_barrier
L_hw:
    s_cmp_lt_u32 s3, s47
    s_cbranch_scc0 L_fds2
    s_mul_i32 s40, s43, 288
    s_add_u32 s40, s40, 22528
    s_movk_i32 s69, 0xff00
    s_mov_b32 s57, 0x0c0c0400
    s_mov_b32 s58, 0x04000c0c
    s_mul_i32 s51, s3, 288
    v_add_u32 v24, s51, v8
    v_lshl_add_u32 v25, v62, 2, s51
    buffer_load_dwordx4 v[124:127], v6, s[4:7], s48 offen nt
    s_add_u32 s48, s48, 9216
    buffer_load_dwordx4 v[128:131], v6, s[4:7], s48 offen nt
    s_add_u32 s48, s48, 9216
    buffer_load_dwordx4 v[132:135], v6, s[4:7], s48 offen nt
    s_add_u32 s48, s48, 9216
    buffer_load_dwordx4 v[136:139], v6, s[4:7], s48 offen nt
    s_add_u32 s48, s48, 9216
    buffer_load_dwordx4 v[140:143], v6, s[4:7], s48 offen nt
    s_add_u32 s48, s48, 9216
    buffer_load_dwordx4 v[144:147], v6, s[4:7], s48 offen nt
    s_add_u32 s48, s48, 9216
    buffer_load_dwordx4 v[148:151], v6, s[4:7], s48 offen nt
    s_add_u32 s48, s48, 9216
    buffer_load_dwordx4 v[152:155], v6, s[4:7], s48 offen nt
    s_add_u32 s48, s48, 9216
    buffer_load_dwordx4 v[156:159], v6, s[4:7], s48 offen nt
    s_mov_b32 s54, 200000
    s_mov_b32 exec_lo, 0x3ffff
    s_mov_b32 exec_hi, 0x0
    s_branch L_hga
L_h7:
    buffer_load_dwordx4 v[96:99], v6, s[4:7], s56 offen nt
    s_add_u32 s56, s56, 9216
    buffer_load_dwordx4 v[100:103], v6, s[4:7], s56 offen nt
    s_add_u32 s56, s56, 9216
    buffer_load_dwordx4 v[104:107], v6, s[4:7], s56 offen nt
    s_add_u32 s56, s56, 9216
    buffer_load_dwordx4 v[108:111], v6, s[4:7], s56 offen nt
    s_add_u32 s56, s56, 9216
    buffer_load_dwordx4 v[112:115], v6, s[4:7], s56 offen nt
    s_add_u32 s56, s56, 9216
    buffer_load_dwordx4 v[116:119], v6, s[4:7], s56 offen nt
    s_add_u32 s56, s56, 9216
    buffer_load_dwordx4 v[120:123], v6, s[4:7], s56 offen nt
    s_add_u32 s56, s56, 9216
    buffer_load_dwordx4 v[124:127], v6, s[4:7], s56 offen nt
    v_lshlrev_b32 v18, 3, v1
    v_lshrrev_b32 v19, 1, v62
    v_and_b32 v20, 1, v62
    v_lshlrev_b32 v19, 2, v19
    v_lshl_add_u32 v19, v20, 7, v19
    v_and_b32 v20, 31, v1
    v_lshrrev_b32 v21, 5, v1
    v_lshl_add_u32 v20, v20, 1, v21
    v_and_b32 v21, 3, v20
    v_lshlrev_b32 v21, 3, v21
    v_mov_b32 v22, s42
    v_lshrrev_b32 v21, v21, v22
    v_lshlrev_b32 v20, 2, v20
    s_lshl_b32 s50, s61, 8
    s_add_u32 s50, s50, 22528
    s_waitcnt lgkmcnt(0)
    s_barrier
    ds_read_b64 v[64:65], v18 offset:6400
    ds_read_b64 v[66:67], v18 offset:6912
    ds_read_b64 v[68:69], v18 offset:7424
    ds_read_b64 v[70:71], v18 offset:7936
    ds_read_b64 v[72:73], v18 offset:8448
    ds_read_b64 v[74:75], v18 offset:8960
    ds_read_b64 v[76:77], v18 offset:9472
    ds_read_b64 v[78:79], v18 offset:9984
    ds_read_b64 v[80:81], v18 offset:10496
    s_waitcnt lgkmcnt(0)
    v_pk_add_f32 v[64:65], v[64:65], v[66:67]
    v_pk_add_f32 v[68:69], v[68:69], v[70:71]
    v_pk_add_f32 v[72:73], v[72:73], v[74:75]
    v_pk_add_f32 v[76:77], v[76:77], v[78:79]
    v_pk_add_f32 v[64:65], v[64:65], v[68:69]
    v_pk_add_f32 v[72:73], v[72:73], v[76:77]
    v_pk_add_f32 v[64:65], v[64:65], v[72:73]
    v_pk_add_f32 v[64:65], v[64:65], v[80:81]
    s_nop 1
    v_permlane32_swap_b32 v64, v65
    s_nop 0
    v_cvt_pk_bf16_f32 v66, v64, v65
    v_lshlrev_b32 v64, 16, v66
    v_and_b32 v65, 0xffff0000, v66
    v_mul_f32 v66, 0xbfb8aa3b, v64
    v_exp_f32 v66, v66
    s_nop 0
    v_add_f32 v66, 1.0, v66
    v_rcp_f32 v66, v66
    s_nop 0
    v_mul_f32 v64, v64, v66
    v_cvt_pk_bf16_f32 v64, v64, v64
    v_and_b32 v64, 0xffff0000, v64
    v_mul_f32 v64, v64, v65
    v_cvt_pk_bf16_f32 v64, v64, v64
    v_bfi_b32 v65, s78, v21, v64
    buffer_store_dword v65, v20, s[16:19], s50 offen sc1
    ds_bpermute_b32 v48, v19, v64 offset:0
    ds_bpermute_b32 v49, v19, v64 offset:16
    ds_bpermute_b32 v50, v19, v64 offset:32
    ds_bpermute_b32 v51, v19, v64 offset:48
    ds_bpermute_b32 v52, v19, v64 offset:64
    ds_bpermute_b32 v53, v19, v64 offset:80
    ds_bpermute_b32 v54, v19, v64 offset:96
    ds_bpermute_b32 v55, v19, v64 offset:112
    s_waitcnt lgkmcnt(0)
    v_and_b32 v32, v48, v2
    v_and_b32 v33, v48, v3
    v_and_b32 v34, v48, v4
    v_and_b32 v35, v48, v5
    s_waitcnt vmcnt(8)
    s_nop 0
    v_mfma_f32_16x16x32_bf16 v[44:47], v[32:35], v[96:99], 0
    v_and_b32 v36, v49, v2
    v_and_b32 v37, v49, v3
    v_and_b32 v38, v49, v4
    v_and_b32 v39, v49, v5
    s_waitcnt vmcnt(7)
    s_nop 0
    v_mfma_f32_16x16x32_bf16 v[44:47], v[36:39], v[100:103], v[44:47]
    v_and_b32 v32, v50, v2
    v_and_b32 v33, v50, v3
    v_and_b32 v34, v50, v4
    v_and_b32 v35, v50, v5
    s_waitcnt vmcnt(6)
    s_nop 0
    v_mfma_f32_16x16x32_bf16 v[44:47], v[32:35], v[104:107], v[44:47]
    v_and_b32 v36, v51, v2
    v_and_b32 v37, v51, v3
    v_and_b32 v38, v51, v4
    v_and_b32 v39, v51, v5
    s_waitcnt vmcnt(5)
    s_nop 0
    v_mfma_f32_16x16x32_bf16 v[44:47], v[36:39], v[108:111], v[44:47]
    v_and_b32 v32, v52, v2
    v_and_b32 v33, v52, v3
    v_and_b32 v34, v52, v4
    v_and_b32 v35, v52, v5
    s_waitcnt vmcnt(4)
    s_nop 0
    v_mfma_f32_16x16x32_bf16 v[44:47], v[32:35], v[112:115], v[44:47]
    v_and_b32 v36, v53, v2
    v_and_b32 v37, v53, v3
    v_and_b32 v38, v53, v4
    v_and_b32 v39, v53, v5
    s_waitcnt vmcnt(3)
    s_nop 0
    v_mfma_f32_16x16x32_bf16 v[44:47], v[36:39], v[116:119], v[44:47]
    v_and_b32 v32, v54, v2
    v_and_b32 v33, v54, v3
    v_and_b32 v34, v54, v4
    v_and_b32 v35, v54, v5
    s_waitcnt vmcnt(2)
    s_nop 0
    v_mfma_f32_16x16x32_bf16 v[44:47], v[32:35], v[120:123], v[44:47]
    v_and_b32 v36, v55, v2
    v_and_b32 v37, v55, v3
    v_and_b32 v38, v55, v4
    v_and_b32 v39, v55, v5
    s_waitcnt vmcnt(1)
    s_nop 0
    v_mfma_f32_16x16x32_bf16 v[44:47], v[36:39], v[124:127], v[44:47]
    s_add_u32 s49, s59, 2097152
    s_nop 6
    v_permlane32_swap_b32 v44, v46
    v_permlane32_swap_b32 v45, v47
    s_nop 0
    v_add_f32_dpp v44, v46, v44 row_ror:8 row_mask:0xf bank_mask:0xf
    v_add_f32_dpp v45, v47, v45 row_ror:8 row_mask:0xf bank_mask:0xf
    v_bfi_b32 v44, s78, v14, v44
    v_bfi_b32 v45, s78, v15, v45
    s_mov_b64 exec, s[72:73]
    s_cbranch_execz L_na3
    buffer_store_dwordx2 v[44:45], v63, s[16:19], s49 offen
L_na3:
    s_mov_b32 exec_lo, 0xff00ff
    s_mov_b32 exec_hi, 0xff00ff
    buffer_store_dwordx2 v[44:45], v63, s[16:19], s59 offen sc1
    s_mov_b64 exec, -1
L_fds2:
    s_cmp_eq_u32 s77, 2
    s_cbranch_scc1 L_fin
    s_movk_i32 s69, 0xff00
    s_mov_b32 s57, 0x0c0c0400
    s_mov_b32 s58, 0x04000c0c
    s_cmp_eq_u32 s3, 8
    s_cbranch_scc1 L_fin8
    v_mov_b32 v64, 0
    v_mov_b32 v65, 0
    v_mov_b32 v66, 0
    v_mov_b32 v67, 0
    s_mov_b32 s54, 200000
    s_barrier
    s_mov_b64 exec, s[62:63]
    s_cbranch_execz L_fpoll_end
L_fpoll:
    buffer_load_dwordx4 v[64:67], v60, s[16:19], s53 offen sc1
    s_sub_u32 s54, s54, 1
    s_cbranch_scc1 L_fpoll_end
    s_cmp_eq_u32 s54, 199700
    s_cbranch_scc0 L_fp1
    v_mov_b32 v60, v61
L_fp1:
    s_waitcnt vmcnt(0)
    v_perm_b32 v30, v65, v64, s57
    v_perm_b32 v31, v67, v66, s58
    v_or_b32 v30, v30, v31
    v_cmpx_ne_u32 vcc, s42, v30
    s_cmp_eq_u64 exec, s[62:63]
    s_cbranch_scc1 L_fsleep
    s_cbranch_execnz L_fpoll
L_fpoll_end:
    s_mov_b64 exec, -1
    v_and_b32 v64, s69, v64
    v_and_b32 v65, s69, v65
    v_and_b32 v66, s69, v66
    v_and_b32 v67, s69, v67
    v_add_f32_dpp v64, v64, v64 row_ror:8 row_mask:0xf bank_mask:0xf
    v_add_f32_dpp v65, v65, v65 row_ror:8 row_mask:0xf bank_mask:0xf
    v_add_f32_dpp v66, v66, v66 row_ror:8 row_mask:0xf bank_mask:0xf
    v_add_f32_dpp v67, v67, v67 row_ror:8 row_mask:0xf bank_mask:0xf
    v_add_f32_dpp v64, v64, v64 row_ror:4 row_mask:0xf bank_mask:0xf
    v_add_f32_dpp v65, v65, v65 row_ror:4 row_mask:0xf bank_mask:0xf
    v_add_f32_dpp v66, v66, v66 row_ror:4 row_mask:0xf bank_mask:0xf
    v_add_f32_dpp v67, v67, v67 row_ror:4 row_mask:0xf bank_mask:0xf
    v_add_f32_dpp v64, v64, v64 row_ror:2 row_mask:0xf bank_mask:0xf
    v_add_f32_dpp v65, v65, v65 row_ror:2 row_mask:0xf bank_mask:0xf
    v_add_f32_dpp v66, v66, v66 row_ror:2 row_mask:0xf bank_mask:0xf
    v_add_f32_dpp v67, v67, v67 row_ror:2 row_mask:0xf bank_mask:0xf
    v_add_f32_dpp v64, v64, v64 row_ror:1 row_mask:0xf bank_mask:0xf
    v_add_f32_dpp v65, v65, v65 row_ror:1 row_mask:0xf bank_mask:0xf
    v_add_f32_dpp v66, v66, v66 row_ror:1 row_mask:0xf bank_mask:0xf
    v_add_f32_dpp v67, v67, v67 row_ror:1 row_mask:0xf bank_mask:0xf
    s_mov_b32 exec_lo, 0x10001
    s_mov_b32 exec_hi, 0x10001
    ds_write_b128 v9, v[64:67] offset:14592
    s_mov_b64 exec, -1
    s_waitcnt lgkmcnt(0)
    s_barrier
    s_or_b32 s49, s61, s3
    s_cbranch_scc1 L_fin
    s_mov_b64 exec, 1
    v_mov_b32 v25, s42
    buffer_store_dword v25, v8, s[16:19], 0 offen offset:0
    s_endpgm
L_fsleep:
    s_sleep 6
    s_branch L_fpoll
L_fin8:
    s_mul_i32 s49, s44, 50688
    s_lshl_b32 s50, s60, 5
    s_add_u32 s49, s49, s50
    s_add_u32 s49, s49, 2727936
    s_movk_i32 s54, 300
    s_mov_b32 exec_lo, 0x3fffff
    s_mov_b32 exec_hi, 0x0
L_lpoll:
    s_sleep 4
    buffer_load_dwordx4 v[64:67], v61, s[16:19], s49 offen sc1
    s_sub_u32 s54, s54, 1
    s_cbranch_scc1 L_lpoll_end
    s_waitcnt vmcnt(0)
    v_perm_b32 v30, v65, v64, s57
    v_perm_b32 v31, v67, v66, s58
    v_or_b32 v30, v30, v31
    v_cmpx_ne_u32 vcc, s42, v30
    s_bcnt1_i32_b64 s50, exec
    s_cmp_gt_u32 s50, 21
    s_cbranch_scc1 L_lpoll
L_lpoll_end:
    s_mov_b64 exec, -1
    s_barrier
    v_mov_b32 v24, 0
    ds_read_b128 v[32:35], v24 offset:6016
    ds_read_b128 v[36:39], v24 offset:6032
    ds_read_b32 v25, v24 offset:6048
    s_waitcnt lgkmcnt(0)
    v_pk_add_f32 v[32:33], v[32:33], v[34:35]
    v_pk_add_f32 v[36:37], v[36:37], v[38:39]
    v_pk_add_f32 v[32:33], v[32:33], v[36:37]
    v_add_f32 v32, v32, v33
    v_add_f32 v32, v32, v25
    v_cvt_pk_bf16_f32 v32, v32, v32
    v_and_b32 v32, 0xffff0000, v32
    v_mul_f32 v32, 0xbfb8aa3b, v32
    v_exp_f32 v32, v32
    s_nop 0
    v_add_f32 v32, 1.0, v32
    v_rcp_f32 v32, v32
    s_nop 0
    v_cvt_pk_bf16_f32 v32, v32, v32
    v_and_b32 v32, 0xffff0000, v32
    v_sub_f32 v33, 1.0, v32
    v_cvt_pk_bf16_f32 v33, v33, v33
    v_and_b32 v33, 0xffff0000, v33
    v_and_b32 v27, 7, v1
    v_lshlrev_b32 v26, 2, v27
    v_lshlrev_b32 v27, 1, v27
    v_add_u32 v26, 14592, v26
    s_lshl_b32 s55, s60, 4
    s_barrier
    ds_read2_b32 v[64:65], v26 offset0:0 offset1:8
    ds_read2_b32 v[66:67], v26 offset0:16 offset1:24
    ds_read2_b32 v[68:69], v26 offset0:32 offset1:40
    ds_read2_b32 v[70:71], v26 offset0:48 offset1:56
    ds_read2_b32 v[72:73], v26 offset0:64 offset1:72
    ds_read2_b32 v[74:75], v26 offset0:80 offset1:88
    ds_read2_b32 v[76:77], v26 offset0:96 offset1:104
    ds_read2_b32 v[78:79], v26 offset0:112 offset1:120
    s_waitcnt lgkmcnt(0)
    v_pk_add_f32 v[64:65], v[64:65], v[66:67]
    v_pk_add_f32 v[68:69], v[68:69], v[70:71]
    v_pk_add_f32 v[76:77], v[76:77], v[78:79]
    v_pk_add_f32 v[64:65], v[64:65], v[72:73]
    v_add_f32 v76, v76, v77
    v_pk_add_f32 v[64:65], v[64:65], v[68:69]
    v_add_f32 v75, v75, v76
    v_add_f32 v64, v64, v65
    v_add_f32 v74, v64, v74
    v_cvt_pk_bf16_f32 v64, v74, v75
    v_lshlrev_b32 v74, 16, v64
    v_and_b32 v75, 0xffff0000, v64
    v_pk_mul_f32 v[74:75], v[74:75], v[32:33]
    v_cvt_pk_bf16_f32 v64, v74, v75
    v_lshlrev_b32 v74, 16, v64
    v_and_b32 v75, 0xffff0000, v64
    v_add_f32 v64, v74, v75
    v_cvt_pk_bf16_f32 v64, v64, v64
    s_mov_b32 exec_lo, 0xff
    s_mov_b32 exec_hi, 0x0
    buffer_store_short v64, v27, s[36:39], s55 offen
L_fin:
L_end:
    s_endpgm
.section .rodata,"a"
.p2align 6
.amdhsa_kernel gated_mix__sliding_block_cached__swiglu_ffn__decode_kernel
  .amdhsa_next_free_vgpr 160
  .amdhsa_next_free_sgpr 80
  .amdhsa_accum_offset 160
  .amdhsa_group_segment_fixed_size 0
  .amdhsa_kernarg_size 104
  .amdhsa_user_sgpr_count 2
  .amdhsa_user_sgpr_kernarg_segment_ptr 1
  .amdhsa_system_sgpr_workgroup_id_x 1
.end_amdhsa_kernel
```
